```python
import torch

def _softmax(x, axis=-1):
    return torch.softmax(x, dim=axis)
def _gelu(x):
    return torch.nn.functional.gelu(x, approximate="tanh")
def _silu(x):
    return torch.nn.functional.silu(x)
def _sigmoid(x):
    return torch.sigmoid(x)
def _layernorm(x, axis=-1, eps=1e-5):
    m = x.mean(dim=axis, keepdim=True)
    v = x.var(dim=axis, keepdim=True, unbiased=False)
    return (x - m) / torch.sqrt(v + eps)
def _scatter_add(tgt, idx, src, axis=0):
    return tgt.clone().index_add_(axis, idx, src)
def _segment_sum(src, seg, n):
    out = torch.zeros((n,) + src.shape[1:], dtype=src.dtype)
    return out.index_add_(0, seg, src)
def _pad(x, pw):
    flat = tuple(v for pair in reversed(pw) for v in pair)
    return torch.nn.functional.pad(x, flat)

kernel_name = 'gated_mix__sliding_block_cached__geglu_ffn__decode'

def setup_inputs():

    _w = (lambda a: (lambda t: t.to(torch.bfloat16) if t.is_floating_point() else t)(torch.as_tensor(a)))
    def _A_setup():
        B, Sq, D = 2, 1, 640
        Hq, Hkv, Sk, Dh = 32, 32, 8192, 128
        assert Hq % Hkv == 0, (Hq, Hkv)
        return {
            "x": _w((lambda *s: torch.randn(*s, dtype=torch.bfloat16) * 0.05)(B, Sq, D)),
            "k_cache": _w((lambda *s: torch.randn(*s, dtype=torch.bfloat16) * 6.4)(B, Hkv, Sk, Dh)),
            "v_cache": _w((lambda *s: torch.randn(*s, dtype=torch.bfloat16) * 0.2)(B, Hkv, Sk, Dh)),
            "wq": _w((lambda *s: torch.randn(*s, dtype=torch.bfloat16) * 6.4)(D, Hq * Dh) * (D ** -0.5)),
            "wo": _w((lambda *s: torch.randn(*s, dtype=torch.bfloat16) * 0.2)(Hq * Dh, D) * ((Hq * Dh) ** -0.5)),
        }
    _A_in = _A_setup()

    def _B_setup():
        B, S, D, F = 2, 1, 640, 1728
        return {
            "x": _w((lambda *s: torch.randn(*s, dtype=torch.bfloat16) * 0.05)(B, S, D)),
            "w_gate": _w((lambda *s: torch.randn(*s, dtype=torch.bfloat16) * 0.05)(D, F)),
            "w_up": _w((lambda *s: torch.randn(*s, dtype=torch.bfloat16) * 0.05)(D, F)),
            "w_down": _w((lambda *s: torch.randn(*s, dtype=torch.bfloat16) * 0.05)(F, D)),
        }
    _B_in = _B_setup()

    return {
        "A_x": _A_in["x"],
        "A_k_cache": _A_in["k_cache"],
        "A_v_cache": _A_in["v_cache"],
        "A_wq": _A_in["wq"],
        "A_wo": _A_in["wo"],
        "B_x": _B_in["x"],
        "B_w_gate": _B_in["w_gate"],
        "B_w_up": _B_in["w_up"],
        "B_w_down": _B_in["w_down"],
        "gate_w": _w((lambda *s: torch.randn(*s, dtype=torch.bfloat16) * 0.05)(640) * 16.0),
    }

def reference(A_x, A_k_cache, A_v_cache, A_wq, A_wo, B_x, B_w_gate, B_w_up, B_w_down, gate_w):
    def _A_ref(x, k_cache, v_cache, wq, wo):
        B, Sq, D = x.shape
        Hq, Dh = 32, 128
        Hkv, Sk = k_cache.shape[1], k_cache.shape[2]
        W = min(4096, max(256, Sk // 4))
        rep = Hq // Hkv
        q = (lambda x, *d: x.permute(*d))((x @ wq).reshape(B, Sq, Hq, Dh), 0, 2, 1, 3)
        k = (lambda x, n, axis: torch.repeat_interleave(x, n, dim=axis))(k_cache[:, :, Sk - W:, :], rep, axis=1)
        v = (lambda x, n, axis: torch.repeat_interleave(x, n, dim=axis))(v_cache[:, :, Sk - W:, :], rep, axis=1)
        scores = torch.einsum("bhqd,bhkd->bhqk", q, k) * (Dh ** -0.5)
        p = _softmax(scores, axis=-1)
        o = torch.einsum("bhqk,bhkd->bhqd", p, v)
        return (lambda x, *d: x.permute(*d))(o, 0, 2, 1, 3).reshape(B, Sq, Hq * Dh) @ wo

    def _B_ref(x, w_gate, w_up, w_down):
        return (_gelu(x @ w_gate) * (x @ w_up)) @ w_down

    x = A_x
    g = _sigmoid((x * gate_w).sum(-1, keepdims=True))
    a = _A_ref(x, A_k_cache, A_v_cache, A_wq, A_wo)
    b = _B_ref(x, B_w_gate, B_w_up, B_w_down)
    return g * a + (1 - g) * b
```

```asm
; @launch grid=(256,1,1) block=(512,1,1) lds=142848
.amdgcn_target "amdgcn-amd-amdhsa--gfx950"
.text
.globl gated_mix__sliding_block_cached__geglu_ffn__decode_kernel
.p2align 8
.type gated_mix__sliding_block_cached__geglu_ffn__decode_kernel,@function
gated_mix__sliding_block_cached__geglu_ffn__decode_kernel:
    s_load_dwordx2 s[40:41], s[0:1], 24
    v_lshrrev_b32 v1, 6, v0
    v_bfe_u32 v2, v0, 4, 2
    v_readfirstlane_b32 s3, v1
    v_and_b32 v3, 15, v0
    s_and_b32 s28, s2, 7
    s_lshr_b32 s64, s2, 6
    s_bfe_u32 s31, s2, 0x30003
    s_mul_i32 s52, s64, 9
    s_and_b32 s52, s52, 17
    s_brev_b32 s30, s28
    s_lshr_b32 s30, s30, 28
    s_or_b32 s30, s30, s52
    s_cmp_gt_u32 s64, 3
    s_cbranch_scc1 L_end
    s_mov_b32 s43, 0x20000
    s_mov_b32 s42, 5242880
    s_and_b32 s34, s3, 3
    s_cmp_ge_u32 s3, 4
    s_cbranch_scc1 L_H
    v_mul_u32_u24 v13, 2560, v2
    v_add_lshl_u32 v13, v13, v3, 4
    s_lshl2_add_u32 s51, s31, s34
    s_mul_i32 s35, s51, 163840
    s_lshl_b32 s52, s30, 8
    s_add_u32 s35, s35, s52
    s_waitcnt lgkmcnt(0)
    buffer_load_dwordx4 v[64:67], v13, s[40:43], s35 offen nt
    s_add_u32 s35, s35, 8192
    s_load_dwordx16 s[4:19], s[0:1], 0
    buffer_load_dwordx4 v[68:71], v13, s[40:43], s35 offen nt
    s_add_u32 s35, s35, 8192
    buffer_load_dwordx4 v[72:75], v13, s[40:43], s35 offen nt
    s_add_u32 s35, s35, 8192
    buffer_load_dwordx4 v[76:79], v13, s[40:43], s35 offen nt
    s_add_u32 s35, s35, 8192
    buffer_load_dwordx4 v[80:83], v13, s[40:43], s35 offen nt
    v_lshrrev_b32 v13, 3, v3
    v_mul_u32_u24 v13, 1280, v13
    v_mul_u32_u24 v14, 10, v2
    v_and_b32 v14, -4, v14
    s_mul_i32 s35, s51, 40
    v_add3_u32 v13, v13, v14, s35
    s_waitcnt lgkmcnt(0)
    global_load_dwordx3 v[16:18], v13, s[4:5]
    s_load_dwordx2 s[36:37], s[0:1], 96
    s_setprio 1
    s_lshr_b32 s35, s31, 2
    s_lshl_b32 s35, s35, 5
    s_add_u32 s35, s35, s30
    s_lshl_b32 s35, s35, 4
    s_and_b32 s52, s31, 3
    s_add_u32 s35, s35, s52
    s_add_u32 s35, s35, 12
    s_lshl_b32 s35, s35, 5
    s_add_u32 s35, s35, s34
    s_lshl_b32 s35, s35, 12
    s_mov_b32 s50, s35
    s_lshl_b32 m0, s34, 15
    s_mov_b32 s40, s6
    s_mov_b32 s41, s7
    s_mov_b32 s42, 134217728
    v_lshlrev_b32 v45, 8, v2
    v_lshlrev_b32 v44, 2, v2
    v_xor_b32 v44, v44, v3
    v_lshl_add_u32 v48, v44, 4, v45
    v_xor_b32 v49, 16, v48
    v_xor_b32 v50, 32, v48
    v_xor_b32 v51, 48, v48
    s_add_u32 s66, s28, 7
    s_and_b32 s66, s66, 7
    s_lshl2_add_u32 s67, s66, s64
    s_barrier
    s_cmp_ge_u32 s67, 27
    s_cbranch_scc1 L_nogu
    v_mov_b32 v14, s16
    v_mov_b32 v15, s17
    v_mov_b32 v20, s18
    v_mov_b32 v21, s19
    v_cmp_gt_u32 vcc, 8, v3
    v_and_b32 v22, 7, v3
    v_lshlrev_b32 v22, 4, v22
    v_cndmask_b32 v14, v20, v14, vcc
    v_cndmask_b32 v15, v21, v15, vcc
    s_mul_i32 s53, s51, 69120
    s_lshl_b32 s52, s67, 7
    s_add_u32 s53, s53, s52
    v_mul_u32_u24 v23, 17280, v2
    v_add3_u32 v22, v22, v23, s53
    v_mov_b32 v23, 0
    s_mov_b32 s52, 3456
    s_mov_b32 s53, 0
    v_lshl_add_u64 v[14:15], v[22:23], 0, v[14:15]
    global_load_dwordx4 v[84:87], v[14:15], off nt
    v_lshl_add_u64 v[14:15], v[14:15], 0, s[52:53]
    s_waitcnt vmcnt(6)
    global_load_dwordx4 v[88:91], v[14:15], off nt
    v_lshl_add_u64 v[14:15], v[14:15], 0, s[52:53]
    s_waitcnt vmcnt(6)
    global_load_dwordx4 v[92:95], v[14:15], off nt
    v_lshl_add_u64 v[14:15], v[14:15], 0, s[52:53]
    s_waitcnt vmcnt(6)
    global_load_dwordx4 v[96:99], v[14:15], off nt
    v_lshl_add_u64 v[14:15], v[14:15], 0, s[52:53]
    s_waitcnt vmcnt(6)
    global_load_dwordx4 v[100:103], v[14:15], off nt
L_nogu:
    s_waitcnt vmcnt(6)
    buffer_load_dwordx4 v48, s[40:43], s35 offen offset:0 nt lds
    v_and_b32 v1, 63, v0
    s_mov_b32 s38, 536870912
    s_mov_b32 s39, 0x20000
    s_mov_b32 s49, 200000
    v_mov_b32 v14, 131328
    v_lshl_add_u32 v15, s34, 2, v14
    v_lshlrev_b32 v13, 4, v1
    v_mov_b32 v45, 0
    v_mov_b32 v54, 1
    s_mov_b32 s44, s8
    s_mov_b32 s45, s9
    s_mov_b32 s46, 134217728
    s_mov_b32 s47, 0x20000
    s_waitcnt vmcnt(5)
    buffer_load_dwordx4 v49, s[40:43], s35 offen offset:1024 nt lds
    s_mov_b32 s62, 0xaaaaaaaa
    s_mov_b32 s63, 0xaaaaaaaa
    v_mov_b32 v20, 0x0c0c0100
    v_mov_b32 v21, 0x01000c0c
    v_cndmask_b32 v20, v20, v21, s[62:63]
    v_mov_b32 v21, 0x0c0c0302
    v_mov_b32 v22, 0x03020c0c
    v_cndmask_b32 v21, v21, v22, s[62:63]
    v_mov_b32 v22, 0x0c0c0c0c
    s_mov_b32 s62, 0x03030303
    s_mov_b32 s63, 0x03030303
    v_cndmask_b32 v4, v22, v20, s[62:63]
    v_cndmask_b32 v5, v22, v21, s[62:63]
    s_lshl_b64 s[62:63], s[62:63], 2
    v_cndmask_b32 v6, v22, v20, s[62:63]
    v_cndmask_b32 v7, v22, v21, s[62:63]
    s_lshl_b64 s[62:63], s[62:63], 2
    v_cndmask_b32 v8, v22, v20, s[62:63]
    v_cndmask_b32 v9, v22, v21, s[62:63]
    s_lshl_b64 s[62:63], s[62:63], 2
    v_cndmask_b32 v10, v22, v20, s[62:63]
    v_cndmask_b32 v11, v22, v21, s[62:63]
    s_waitcnt vmcnt(5)
    buffer_load_dwordx4 v50, s[40:43], s35 offen offset:2048 nt lds
    v_and_b32 v19, 1, v2
    v_lshlrev_b32 v19, 4, v19
    s_lshl_b32 s52, s34, 11
    s_add_u32 s52, s52, 134656
    v_add_u32 v46, s52, v13
    s_waitcnt lgkmcnt(0)
    s_load_dword s32, s[36:37], 0
    s_waitcnt vmcnt(5)
    buffer_load_dwordx4 v51, s[40:43], s35 offen offset:3072 nt lds
    s_add_u32 m0, m0, 4096
    s_add_u32 s35, s35, 16384
    s_waitcnt vmcnt(5)
    buffer_load_dwordx4 v48, s[40:43], s35 offen offset:0 nt lds
    s_waitcnt vmcnt(5)
    buffer_load_dwordx4 v49, s[40:43], s35 offen offset:1024 nt lds
    v_alignbit_b32 v20, v17, v16, v19
    v_alignbit_b32 v21, v18, v17, v19
    v_alignbit_b32 v22, v18, v18, v19
    v_perm_b32 v32, v20, v20, v4
    v_perm_b32 v33, v20, v20, v6
    v_perm_b32 v34, v20, v20, v8
    v_perm_b32 v35, v20, v20, v10
    s_nop 1
    v_mfma_f32_16x16x32_bf16 v[24:27], v[32:35], v[64:67], 0
    v_mfma_f32_16x16x32_bf16 v[28:31], v[32:35], v[84:87], 0
    v_perm_b32 v36, v20, v20, v5
    v_perm_b32 v37, v20, v20, v7
    v_perm_b32 v38, v20, v20, v9
    v_perm_b32 v39, v20, v20, v11
    s_nop 1
    v_mfma_f32_16x16x32_bf16 v[24:27], v[36:39], v[68:71], v[24:27]
    v_mfma_f32_16x16x32_bf16 v[28:31], v[36:39], v[88:91], v[28:31]
    s_waitcnt vmcnt(5)
    buffer_load_dwordx4 v50, s[40:43], s35 offen offset:2048 nt lds
    v_perm_b32 v32, v21, v21, v4
    v_perm_b32 v33, v21, v21, v6
    v_perm_b32 v34, v21, v21, v8
    v_perm_b32 v35, v21, v21, v10
    s_nop 1
    v_mfma_f32_16x16x32_bf16 v[24:27], v[32:35], v[72:75], v[24:27]
    v_mfma_f32_16x16x32_bf16 v[28:31], v[32:35], v[92:95], v[28:31]
    v_perm_b32 v36, v21, v21, v5
    v_perm_b32 v37, v21, v21, v7
    v_perm_b32 v38, v21, v21, v9
    v_perm_b32 v39, v21, v21, v11
    s_nop 1
    v_mfma_f32_16x16x32_bf16 v[24:27], v[36:39], v[76:79], v[24:27]
    v_mfma_f32_16x16x32_bf16 v[28:31], v[36:39], v[96:99], v[28:31]
    s_waitcnt vmcnt(5)
    buffer_load_dwordx4 v51, s[40:43], s35 offen offset:3072 nt lds
    s_add_u32 m0, m0, 4096
    s_add_u32 s35, s35, 16384
    v_perm_b32 v32, v22, v22, v4
    v_perm_b32 v33, v22, v22, v6
    v_perm_b32 v34, v22, v22, v8
    v_perm_b32 v35, v22, v22, v10
    s_nop 1
    v_mfma_f32_16x16x32_bf16 v[24:27], v[32:35], v[80:83], v[24:27]
    v_mfma_f32_16x16x32_bf16 v[28:31], v[32:35], v[100:103], v[28:31]
    s_nop 7
    ds_write_b128 v46, v[24:27]
    ds_write_b128 v46, v[28:31] offset:1024
    s_mov_b64 exec, 1
    ds_add_u32 v14, v54 offset:12
    s_mov_b64 exec, -1
    s_waitcnt vmcnt(5)
    buffer_load_dwordx4 v48, s[40:43], s35 offen offset:0 nt lds
    s_waitcnt vmcnt(5)
    buffer_load_dwordx4 v49, s[40:43], s35 offen offset:1024 nt lds
    v_add_u32 v45, 1, v45
    ds_write_b32 v15, v45 offset:32
    s_waitcnt vmcnt(5)
    buffer_load_dwordx4 v50, s[40:43], s35 offen offset:2048 nt lds
    s_waitcnt vmcnt(5)
    buffer_load_dwordx4 v51, s[40:43], s35 offen offset:3072 nt lds
    s_add_u32 m0, m0, 4096
    s_add_u32 s35, s35, 16384
    s_waitcnt vmcnt(5)
    buffer_load_dwordx4 v48, s[40:43], s35 offen offset:0 nt lds
    s_waitcnt vmcnt(5)
    buffer_load_dwordx4 v49, s[40:43], s35 offen offset:1024 nt lds
    v_add_u32 v45, 1, v45
    ds_write_b32 v15, v45 offset:32
    s_waitcnt vmcnt(5)
    buffer_load_dwordx4 v50, s[40:43], s35 offen offset:2048 nt lds
    s_waitcnt vmcnt(5)
    buffer_load_dwordx4 v51, s[40:43], s35 offen offset:3072 nt lds
    s_add_u32 m0, m0, 4096
    s_add_u32 s35, s35, 16384
    s_waitcnt vmcnt(5)
    buffer_load_dwordx4 v48, s[40:43], s35 offen offset:0 nt lds
    s_waitcnt vmcnt(5)
    buffer_load_dwordx4 v49, s[40:43], s35 offen offset:1024 nt lds
    v_add_u32 v45, 1, v45
    ds_write_b32 v15, v45 offset:32
    s_waitcnt vmcnt(5)
    buffer_load_dwordx4 v50, s[40:43], s35 offen offset:2048 nt lds
    s_waitcnt vmcnt(5)
    buffer_load_dwordx4 v51, s[40:43], s35 offen offset:3072 nt lds
    s_add_u32 m0, m0, 4096
    s_add_u32 s35, s35, 16384
    s_waitcnt vmcnt(5)
    buffer_load_dwordx4 v48, s[40:43], s35 offen offset:0 nt lds
    s_waitcnt vmcnt(5)
    buffer_load_dwordx4 v49, s[40:43], s35 offen offset:1024 nt lds
    v_add_u32 v45, 1, v45
    ds_write_b32 v15, v45 offset:32
    s_waitcnt vmcnt(5)
    buffer_load_dwordx4 v50, s[40:43], s35 offen offset:2048 nt lds
    s_waitcnt vmcnt(5)
    buffer_load_dwordx4 v51, s[40:43], s35 offen offset:3072 nt lds
    s_add_u32 m0, m0, 4096
    s_add_u32 s35, s35, 16384
    s_waitcnt vmcnt(5)
    buffer_load_dwordx4 v48, s[40:43], s35 offen offset:0 nt lds
    s_waitcnt vmcnt(5)
    buffer_load_dwordx4 v49, s[40:43], s35 offen offset:1024 nt lds
    v_add_u32 v45, 1, v45
    ds_write_b32 v15, v45 offset:32
    s_waitcnt vmcnt(5)
    buffer_load_dwordx4 v50, s[40:43], s35 offen offset:2048 nt lds
    s_waitcnt vmcnt(5)
    buffer_load_dwordx4 v51, s[40:43], s35 offen offset:3072 nt lds
    s_add_u32 m0, m0, 4096
    s_add_u32 s35, s35, 16384
    s_waitcnt vmcnt(5)
    buffer_load_dwordx4 v48, s[40:43], s35 offen offset:0 nt lds
    s_waitcnt lgkmcnt(0)
    s_add_u32 s32, s32, 1
    s_and_b32 s68, s32, 0xff
    s_mov_b32 s33, s68
    v_mov_b32 v12, 0xffffff00
    s_lshr_b32 s69, s32, 8
    s_add_u32 s69, s69, s32
    s_and_b32 s69, s69, 0xff
    s_lshl_b32 s48, s69, 8
    s_or_b32 s33, s33, s48
    s_lshr_b32 s70, s32, 16
    s_add_u32 s70, s70, s32
    s_and_b32 s70, s70, 0xff
    s_lshl_b32 s48, s70, 16
    s_or_b32 s33, s33, s48
    s_lshr_b32 s71, s32, 24
    s_add_u32 s71, s71, s32
    s_and_b32 s71, s71, 0xff
    s_lshl_b32 s48, s71, 24
    s_or_b32 s33, s33, s48
    s_waitcnt vmcnt(5)
    buffer_load_dwordx4 v49, s[40:43], s35 offen offset:1024 nt lds
    v_add_u32 v45, 1, v45
    ds_write_b32 v15, v45 offset:32
    s_waitcnt vmcnt(5)
    buffer_load_dwordx4 v50, s[40:43], s35 offen offset:2048 nt lds
    s_xor_b32 s33, s33, 0x80808080
    v_and_b32 v55, 1, v1
    v_lshlrev_b32 v62, 4, v55
    v_add_u32 v63, 8, v62
    v_bfe_u32 v62, s33, v62, 8
    v_bfe_u32 v63, s33, v63, 8
    v_lshlrev_b32 v52, 3, v1
    v_add_u32 v52, 132608, v52
    s_lshl_b32 s54, s34, 9
    s_add_u32 s54, s54, 132608
    v_lshl_add_u32 v53, v2, 4, s54
    v_lshl_add_u32 v53, v3, 5, v53
    v_lshrrev_b32 v44, 1, v1
    v_lshlrev_b32 v55, 3, v55
    v_lshl_add_u32 v55, v44, 7, v55
    s_lshl_b32 s55, s30, 9
    s_add_u32 s55, s55, s31
    s_lshl_b32 s55, s55, 4
    s_add_u32 s55, s55, 4096
    s_lshl_b32 s54, s34, 8
    s_add_u32 s54, s54, 131584
    v_lshl_add_u32 v46, v2, 6, s54
    v_lshl_add_u32 v47, s34, 3, v14
    s_waitcnt vmcnt(5)
    buffer_load_dwordx4 v51, s[40:43], s35 offen offset:3072 nt lds
    s_waitcnt vmcnt(5)
    buffer_load_dwordx4 v[64:67], v13, s[44:47], s50 offen offset:0 nt
    s_waitcnt vmcnt(5)
    buffer_load_dwordx4 v[68:71], v13, s[44:47], s50 offen offset:1024 nt
    v_add_u32 v45, 1, v45
    ds_write_b32 v15, v45 offset:32
    s_waitcnt vmcnt(5)
    buffer_load_dwordx4 v[72:75], v13, s[44:47], s50 offen offset:2048 nt
    s_waitcnt vmcnt(5)
    buffer_load_dwordx4 v[76:79], v13, s[44:47], s50 offen offset:3072 nt
    s_add_u32 s50, s50, 16384
    s_waitcnt vmcnt(5)
    buffer_load_dwordx4 v[80:83], v13, s[44:47], s50 offen offset:0 nt
    s_waitcnt vmcnt(5)
    buffer_load_dwordx4 v[84:87], v13, s[44:47], s50 offen offset:1024 nt
    v_add_u32 v45, 1, v45
    ds_write_b32 v15, v45 offset:32
    s_waitcnt vmcnt(5)
    buffer_load_dwordx4 v[88:91], v13, s[44:47], s50 offen offset:2048 nt
    s_waitcnt vmcnt(5)
    buffer_load_dwordx4 v[92:95], v13, s[44:47], s50 offen offset:3072 nt
    s_add_u32 s50, s50, 16384
    s_waitcnt vmcnt(5)
    buffer_load_dwordx4 v[96:99], v13, s[44:47], s50 offen offset:0 nt
    s_waitcnt vmcnt(5)
    buffer_load_dwordx4 v[100:103], v13, s[44:47], s50 offen offset:1024 nt
    v_add_u32 v45, 1, v45
    ds_write_b32 v15, v45 offset:32
    s_waitcnt vmcnt(5)
    buffer_load_dwordx4 v[104:107], v13, s[44:47], s50 offen offset:2048 nt
    s_waitcnt vmcnt(5)
    buffer_load_dwordx4 v[108:111], v13, s[44:47], s50 offen offset:3072 nt
    s_add_u32 s50, s50, 16384
    s_waitcnt vmcnt(5)
    buffer_load_dwordx4 v[112:115], v13, s[44:47], s50 offen offset:0 nt
    s_waitcnt vmcnt(5)
    buffer_load_dwordx4 v[116:119], v13, s[44:47], s50 offen offset:1024 nt
    v_add_u32 v45, 1, v45
    ds_write_b32 v15, v45 offset:32
    s_waitcnt vmcnt(5)
    buffer_load_dwordx4 v[120:123], v13, s[44:47], s50 offen offset:2048 nt
    s_waitcnt vmcnt(5)
    buffer_load_dwordx4 v[124:127], v13, s[44:47], s50 offen offset:3072 nt
    s_add_u32 s50, s50, 16384
    s_waitcnt vmcnt(5)
    buffer_load_dwordx4 v[128:131], v13, s[44:47], s50 offen offset:0 nt
    s_waitcnt vmcnt(5)
    buffer_load_dwordx4 v[132:135], v13, s[44:47], s50 offen offset:1024 nt
    s_waitcnt vmcnt(5)
    buffer_load_dwordx4 v[136:139], v13, s[44:47], s50 offen offset:2048 nt
    s_waitcnt vmcnt(5)
    buffer_load_dwordx4 v[140:143], v13, s[44:47], s50 offen offset:3072 nt
    s_add_u32 s50, s50, 16384
L_pwait:
    ds_read_b32 v44, v14 offset:16
    s_waitcnt lgkmcnt(0)
    v_cmp_le_u32 vcc, 4, v44
    s_cbranch_vccnz L_pwait_ok
    s_sleep 1
    s_sub_u32 s49, s49, 1
    s_cbranch_scc0 L_pwait
    s_endpgm
L_pwait_ok:
    ds_read_b128 v[16:19], v46 offset:0
    ds_read_b128 v[20:23], v46 offset:16
    ds_read_b128 v[24:27], v46 offset:32
    ds_read_b128 v[28:31], v46 offset:48
    ds_read_b128 v[48:51], v14 offset:64
    ds_read_b128 v[56:59], v14 offset:80
    ds_read_b32 v47, v47 offset:64
    ds_read_b32 v44, v14 offset:48
    s_waitcnt vmcnt(5)
    buffer_load_dwordx4 v[144:147], v13, s[44:47], s50 offen offset:0 nt
    s_waitcnt lgkmcnt(0)
    v_max_f32 v60, v48, v50
    v_max3_f32 v60, v60, v56, v58
    v_readfirstlane_b32 s65, v44
    v_sub_f32 v47, v47, v60
    v_mul_f32 v47, 0x3fb8aa3b, v47
    v_exp_f32 v47, v47
    s_waitcnt vmcnt(5)
    buffer_load_dwordx4 v[148:151], v13, s[44:47], s50 offen offset:1024 nt
    v_perm_b32 v32, v16, v16, v4
    v_perm_b32 v33, v16, v16, v6
    v_perm_b32 v34, v16, v16, v8
    v_perm_b32 v35, v16, v16, v10
    s_nop 1
    v_mfma_f32_16x16x32_bf16 v[40:43], v[32:35], v[64:67], 0
    v_perm_b32 v36, v16, v16, v5
    v_perm_b32 v37, v16, v16, v7
    v_perm_b32 v38, v16, v16, v9
    v_perm_b32 v39, v16, v16, v11
    s_nop 1
    v_mfma_f32_16x16x32_bf16 v[40:43], v[36:39], v[68:71], v[40:43]
    v_perm_b32 v32, v17, v17, v4
    v_perm_b32 v33, v17, v17, v6
    v_perm_b32 v34, v17, v17, v8
    v_perm_b32 v35, v17, v17, v10
    s_nop 1
    v_mfma_f32_16x16x32_bf16 v[40:43], v[32:35], v[72:75], v[40:43]
    s_waitcnt vmcnt(5)
    buffer_load_dwordx4 v[152:155], v13, s[44:47], s50 offen offset:2048 nt
    v_perm_b32 v36, v17, v17, v5
    v_perm_b32 v37, v17, v17, v7
    v_perm_b32 v38, v17, v17, v9
    v_perm_b32 v39, v17, v17, v11
    s_nop 1
    v_mfma_f32_16x16x32_bf16 v[40:43], v[36:39], v[76:79], v[40:43]
    v_perm_b32 v32, v18, v18, v4
    v_perm_b32 v33, v18, v18, v6
    v_perm_b32 v34, v18, v18, v8
    v_perm_b32 v35, v18, v18, v10
    s_nop 1
    v_mfma_f32_16x16x32_bf16 v[40:43], v[32:35], v[80:83], v[40:43]
    v_perm_b32 v36, v18, v18, v5
    v_perm_b32 v37, v18, v18, v7
    v_perm_b32 v38, v18, v18, v9
    v_perm_b32 v39, v18, v18, v11
    s_nop 1
    v_mfma_f32_16x16x32_bf16 v[40:43], v[36:39], v[84:87], v[40:43]
    s_waitcnt vmcnt(5)
    buffer_load_dwordx4 v[156:159], v13, s[44:47], s50 offen offset:3072 nt
    s_add_u32 s50, s50, 16384
    v_perm_b32 v32, v19, v19, v4
    v_perm_b32 v33, v19, v19, v6
    v_perm_b32 v34, v19, v19, v8
    v_perm_b32 v35, v19, v19, v10
    s_nop 1
    v_mfma_f32_16x16x32_bf16 v[40:43], v[32:35], v[88:91], v[40:43]
    v_perm_b32 v36, v19, v19, v5
    v_perm_b32 v37, v19, v19, v7
    v_perm_b32 v38, v19, v19, v9
    v_perm_b32 v39, v19, v19, v11
    s_nop 1
    v_mfma_f32_16x16x32_bf16 v[40:43], v[36:39], v[92:95], v[40:43]
    v_perm_b32 v32, v20, v20, v4
    v_perm_b32 v33, v20, v20, v6
    v_perm_b32 v34, v20, v20, v8
    v_perm_b32 v35, v20, v20, v10
    s_nop 1
    v_mfma_f32_16x16x32_bf16 v[40:43], v[32:35], v[96:99], v[40:43]
    s_waitcnt vmcnt(5)
    buffer_load_dwordx4 v[160:163], v13, s[44:47], s50 offen offset:0 nt
    v_perm_b32 v36, v20, v20, v5
    v_perm_b32 v37, v20, v20, v7
    v_perm_b32 v38, v20, v20, v9
    v_perm_b32 v39, v20, v20, v11
    s_nop 1
    v_mfma_f32_16x16x32_bf16 v[40:43], v[36:39], v[100:103], v[40:43]
    v_perm_b32 v32, v21, v21, v4
    v_perm_b32 v33, v21, v21, v6
    v_perm_b32 v34, v21, v21, v8
    v_perm_b32 v35, v21, v21, v10
    s_nop 1
    v_mfma_f32_16x16x32_bf16 v[40:43], v[32:35], v[104:107], v[40:43]
    v_perm_b32 v36, v21, v21, v5
    v_perm_b32 v37, v21, v21, v7
    v_perm_b32 v38, v21, v21, v9
    v_perm_b32 v39, v21, v21, v11
    s_nop 1
    v_mfma_f32_16x16x32_bf16 v[40:43], v[36:39], v[108:111], v[40:43]
    s_waitcnt vmcnt(5)
    buffer_load_dwordx4 v[164:167], v13, s[44:47], s50 offen offset:1024 nt
    v_perm_b32 v32, v22, v22, v4
    v_perm_b32 v33, v22, v22, v6
    v_perm_b32 v34, v22, v22, v8
    v_perm_b32 v35, v22, v22, v10
    s_nop 1
    v_mfma_f32_16x16x32_bf16 v[40:43], v[32:35], v[112:115], v[40:43]
    v_perm_b32 v36, v22, v22, v5
    v_perm_b32 v37, v22, v22, v7
    v_perm_b32 v38, v22, v22, v9
    v_perm_b32 v39, v22, v22, v11
    s_nop 1
    v_mfma_f32_16x16x32_bf16 v[40:43], v[36:39], v[116:119], v[40:43]
    v_perm_b32 v32, v23, v23, v4
    v_perm_b32 v33, v23, v23, v6
    v_perm_b32 v34, v23, v23, v8
    v_perm_b32 v35, v23, v23, v10
    s_nop 1
    v_mfma_f32_16x16x32_bf16 v[40:43], v[32:35], v[120:123], v[40:43]
    s_waitcnt vmcnt(5)
    buffer_load_dwordx4 v[168:171], v13, s[44:47], s50 offen offset:2048 nt
L_wwait:
    ds_read_b64 v[56:57], v14 offset:56
    s_waitcnt lgkmcnt(0)
    v_cmp_ne_u32 vcc, 0, v57
    s_cbranch_vccz L_wwait_re
    v_mul_f32 v46, v47, v56
    v_mul_f32 v47, v47, v56
    v_perm_b32 v36, v23, v23, v5
    v_perm_b32 v37, v23, v23, v7
    v_perm_b32 v38, v23, v23, v9
    v_perm_b32 v39, v23, v23, v11
    s_nop 1
    v_mfma_f32_16x16x32_bf16 v[40:43], v[36:39], v[124:127], v[40:43]
    v_perm_b32 v32, v24, v24, v4
    v_perm_b32 v33, v24, v24, v6
    v_perm_b32 v34, v24, v24, v8
    v_perm_b32 v35, v24, v24, v10
    s_nop 1
    v_mfma_f32_16x16x32_bf16 v[40:43], v[32:35], v[128:131], v[40:43]
    v_perm_b32 v36, v24, v24, v5
    v_perm_b32 v37, v24, v24, v7
    v_perm_b32 v38, v24, v24, v9
    v_perm_b32 v39, v24, v24, v11
    s_nop 1
    v_mfma_f32_16x16x32_bf16 v[40:43], v[36:39], v[132:135], v[40:43]
    s_waitcnt vmcnt(5)
    buffer_load_dwordx4 v[172:175], v13, s[44:47], s50 offen offset:3072 nt
    s_add_u32 s50, s50, 16384
    v_perm_b32 v32, v25, v25, v4
    v_perm_b32 v33, v25, v25, v6
    v_perm_b32 v34, v25, v25, v8
    v_perm_b32 v35, v25, v25, v10
    s_nop 1
    v_mfma_f32_16x16x32_bf16 v[40:43], v[32:35], v[136:139], v[40:43]
    v_perm_b32 v36, v25, v25, v5
    v_perm_b32 v37, v25, v25, v7
    v_perm_b32 v38, v25, v25, v9
    v_perm_b32 v39, v25, v25, v11
    s_nop 1
    v_mfma_f32_16x16x32_bf16 v[40:43], v[36:39], v[140:143], v[40:43]
    v_perm_b32 v32, v26, v26, v4
    v_perm_b32 v33, v26, v26, v6
    v_perm_b32 v34, v26, v26, v8
    v_perm_b32 v35, v26, v26, v10
    s_nop 1
    v_mfma_f32_16x16x32_bf16 v[40:43], v[32:35], v[144:147], v[40:43]
    s_waitcnt vmcnt(5)
    buffer_load_dwordx4 v[176:179], v13, s[44:47], s50 offen offset:0 nt
    v_perm_b32 v36, v26, v26, v5
    v_perm_b32 v37, v26, v26, v7
    v_perm_b32 v38, v26, v26, v9
    v_perm_b32 v39, v26, v26, v11
    s_nop 1
    v_mfma_f32_16x16x32_bf16 v[40:43], v[36:39], v[148:151], v[40:43]
    v_perm_b32 v32, v27, v27, v4
    v_perm_b32 v33, v27, v27, v6
    v_perm_b32 v34, v27, v27, v8
    v_perm_b32 v35, v27, v27, v10
    s_nop 1
    v_mfma_f32_16x16x32_bf16 v[40:43], v[32:35], v[152:155], v[40:43]
    s_waitcnt vmcnt(5)
    buffer_load_dwordx4 v[180:183], v13, s[44:47], s50 offen offset:1024 nt
    v_perm_b32 v36, v27, v27, v5
    v_perm_b32 v37, v27, v27, v7
    v_perm_b32 v38, v27, v27, v9
    v_perm_b32 v39, v27, v27, v11
    s_nop 1
    v_mfma_f32_16x16x32_bf16 v[40:43], v[36:39], v[156:159], v[40:43]
    s_waitcnt vmcnt(5)
    buffer_load_dwordx4 v[184:187], v13, s[44:47], s50 offen offset:2048 nt
    v_perm_b32 v32, v28, v28, v4
    v_perm_b32 v33, v28, v28, v6
    v_perm_b32 v34, v28, v28, v8
    v_perm_b32 v35, v28, v28, v10
    s_nop 1
    v_mfma_f32_16x16x32_bf16 v[40:43], v[32:35], v[160:163], v[40:43]
    s_waitcnt vmcnt(5)
    buffer_load_dwordx4 v[188:191], v13, s[44:47], s50 offen offset:3072 nt
    v_add_u32 v45, 1, v45
    ds_write_b32 v15, v45 offset:32
    v_perm_b32 v36, v28, v28, v5
    v_perm_b32 v37, v28, v28, v7
    v_perm_b32 v38, v28, v28, v9
    v_perm_b32 v39, v28, v28, v11
    s_nop 1
    v_mfma_f32_16x16x32_bf16 v[40:43], v[36:39], v[164:167], v[40:43]
    .p2align 3
    v_perm_b32 v32, v29, v29, v4
    v_perm_b32 v33, v29, v29, v6
    v_perm_b32 v34, v29, v29, v8
    v_perm_b32 v35, v29, v29, v10
    s_nop 0
    s_waitcnt vmcnt(5)
    v_mfma_f32_16x16x32_bf16 v[40:43], v[32:35], v[168:171], v[40:43]
    v_perm_b32 v36, v29, v29, v5
    v_perm_b32 v37, v29, v29, v7
    v_perm_b32 v38, v29, v29, v9
    v_perm_b32 v39, v29, v29, v11
    s_nop 0
    s_waitcnt vmcnt(4)
    v_mfma_f32_16x16x32_bf16 v[40:43], v[36:39], v[172:175], v[40:43]
    v_perm_b32 v32, v30, v30, v4
    v_perm_b32 v33, v30, v30, v6
    v_perm_b32 v34, v30, v30, v8
    v_perm_b32 v35, v30, v30, v10
    s_nop 0
    s_waitcnt vmcnt(3)
    v_mfma_f32_16x16x32_bf16 v[40:43], v[32:35], v[176:179], v[40:43]
    s_mov_b64 exec, 1
    ds_add_u32 v14, v54 offset:20
    s_mov_b64 exec, -1
    v_perm_b32 v36, v30, v30, v5
    v_perm_b32 v37, v30, v30, v7
    v_perm_b32 v38, v30, v30, v9
    v_perm_b32 v39, v30, v30, v11
    s_nop 0
    s_waitcnt vmcnt(2)
    v_mfma_f32_16x16x32_bf16 v[40:43], v[36:39], v[180:183], v[40:43]
    v_perm_b32 v32, v31, v31, v4
    v_perm_b32 v33, v31, v31, v6
    v_perm_b32 v34, v31, v31, v8
    v_perm_b32 v35, v31, v31, v10
    s_nop 0
    s_waitcnt vmcnt(1)
    v_mfma_f32_16x16x32_bf16 v[40:43], v[32:35], v[184:187], v[40:43]
    v_perm_b32 v36, v31, v31, v5
    v_perm_b32 v37, v31, v31, v7
    v_perm_b32 v38, v31, v31, v9
    v_perm_b32 v39, v31, v31, v11
    s_nop 0
    s_waitcnt vmcnt(0)
    v_mfma_f32_16x16x32_bf16 v[40:43], v[36:39], v[188:191], v[40:43]
    s_mov_b32 exec_hi, 0
    s_nop 6
    v_pk_mul_f32 v[40:41], v[46:47], v[40:41]
    v_pk_mul_f32 v[42:43], v[46:47], v[42:43]
    ds_write_b128 v53, v[40:43]
    s_mov_b32 exec_lo, 1
    ds_add_rtn_u32 v54, v14, v54 offset:4
    s_mov_b64 exec, -1
    ds_read2st64_b64 v[16:19], v52 offset1:1
    ds_read2st64_b64 v[20:23], v52 offset0:2 offset1:3
    s_cmp_eq_u32 s65, 2
    s_waitcnt lgkmcnt(1)
    v_pk_add_f32 v[16:17], v[16:17], v[18:19]
    v_cmp_eq_u32 vcc, 3, v54
    s_waitcnt lgkmcnt(0)
    v_pk_add_f32 v[20:21], v[20:21], v[22:23]
    s_cbranch_vccz L_end
    v_pk_add_f32 v[16:17], v[16:17], v[20:21]
    v_and_or_b32 v16, v16, v12, v62
    v_and_or_b32 v17, v17, v12, v63
    s_cbranch_scc0 L_pl1
    buffer_store_dwordx2 v[16:17], v55, s[36:39], s55 offen
L_pd1:
L_end:
    s_endpgm
L_wwait_re:
    s_sleep 1
    s_sub_u32 s49, s49, 1
    s_cbranch_scc0 L_wwait
    s_endpgm
L_pl1:
    buffer_store_dwordx2 v[16:17], v55, s[36:39], s55 offen sc1
    s_branch L_pd1
L_H:
    s_load_dwordx2 s[36:37], s[0:1], 96
    s_load_dwordx16 s[4:19], s[0:1], 0
    s_load_dwordx8 s[20:27], s[0:1], 64
    v_mov_b64 v[4:5], 0
    v_mov_b32 v24, 131328
    v_lshl_add_u32 v15, v3, 3, v24
    ds_write_b64 v15, v[4:5]
    s_mov_b32 s38, 536870912
    s_mov_b32 s39, 0x20000
    s_mov_b32 s49, 200000
    s_lshl3_add_u32 s29, s30, s31
    v_and_b32 v1, 63, v0
    v_lshl_add_u32 v25, s34, 2, v24
    s_waitcnt lgkmcnt(0)
    s_load_dword s32, s[36:37], 0
    s_barrier
    s_add_u32 s66, s28, 7
    s_and_b32 s66, s66, 7
    s_lshl2_add_u32 s67, s66, s64
    s_mov_b32 s62, 0xaaaaaaaa
    s_mov_b32 s63, 0xaaaaaaaa
    v_mov_b32 v20, 0x0c0c0100
    v_mov_b32 v21, 0x01000c0c
    v_cndmask_b32 v20, v20, v21, s[62:63]
    v_mov_b32 v21, 0x0c0c0302
    v_mov_b32 v22, 0x03020c0c
    v_cndmask_b32 v21, v21, v22, s[62:63]
    v_mov_b32 v22, 0x0c0c0c0c
    s_mov_b32 s62, 0x03030303
    s_mov_b32 s63, 0x03030303
    v_cndmask_b32 v4, v22, v20, s[62:63]
    v_cndmask_b32 v5, v22, v21, s[62:63]
    s_lshl_b64 s[62:63], s[62:63], 2
    v_cndmask_b32 v6, v22, v20, s[62:63]
    v_cndmask_b32 v7, v22, v21, s[62:63]
    s_lshl_b64 s[62:63], s[62:63], 2
    v_cndmask_b32 v8, v22, v20, s[62:63]
    v_cndmask_b32 v9, v22, v21, s[62:63]
    s_lshl_b64 s[62:63], s[62:63], 2
    v_cndmask_b32 v10, v22, v20, s[62:63]
    v_cndmask_b32 v11, v22, v21, s[62:63]
    s_waitcnt lgkmcnt(0)
    s_add_u32 s32, s32, 1
    s_and_b32 s68, s32, 0xff
    s_mov_b32 s33, s68
    v_mov_b32 v12, 0xffffff00
    s_lshr_b32 s69, s32, 8
    s_add_u32 s69, s69, s32
    s_and_b32 s69, s69, 0xff
    s_lshl_b32 s48, s69, 8
    s_or_b32 s33, s33, s48
    s_lshr_b32 s70, s32, 16
    s_add_u32 s70, s70, s32
    s_and_b32 s70, s70, 0xff
    s_lshl_b32 s48, s70, 16
    s_or_b32 s33, s33, s48
    s_lshr_b32 s71, s32, 24
    s_add_u32 s71, s71, s32
    s_and_b32 s71, s71, 0xff
    s_lshl_b32 s48, s71, 24
    s_or_b32 s33, s33, s48
    s_cmp_eq_u32 s34, 0
    s_cbranch_scc1 L_h0
    s_cmp_lg_u32 s2, 0
    s_cbranch_scc1 L_hq
    s_cmp_eq_u32 s34, 1
    s_cbranch_scc1 L_h1
    s_cmp_eq_u32 s34, 3
    s_cbranch_scc1 L_hq
    s_add_u32 s52, s36, 1835008
    s_addc_u32 s53, s37, 0
    s_load_dword s54, s[52:53], 0 glc
    s_load_dword s55, s[52:53], 8192 glc
    s_load_dword s54, s[52:53], 4352 glc
    s_load_dword s55, s[52:53], 12544 glc
    s_load_dword s54, s[52:53], 16896 glc
    s_load_dword s55, s[52:53], 25088 glc
    s_load_dword s54, s[52:53], 21248 glc
    s_load_dword s55, s[52:53], 29440 glc
    s_load_dword s54, s[52:53], 1024 glc
    s_load_dword s55, s[52:53], 9216 glc
    s_mov_b32 s57, 0
    s_waitcnt lgkmcnt(0)
    s_mov_b32 s55, s32
    s_load_dword s54, s[52:53], 0 glc
    s_load_dword s55, s[52:53], 8192 glc
    s_waitcnt lgkmcnt(1)
    s_nop 3
    s_mov_b32 s56, s55
    s_waitcnt lgkmcnt(0)
    s_cmp_eq_u32 s56, s55
    s_addc_u32 s57, s57, 0
    s_mov_b32 s55, s32
    s_load_dword s54, s[52:53], 4352 glc
    s_load_dword s55, s[52:53], 12544 glc
    s_waitcnt lgkmcnt(1)
    s_nop 3
    s_mov_b32 s56, s55
    s_waitcnt lgkmcnt(0)
    s_cmp_eq_u32 s56, s55
    s_addc_u32 s57, s57, 0
    s_mov_b32 s55, s32
    s_load_dword s54, s[52:53], 16896 glc
    s_load_dword s55, s[52:53], 25088 glc
    s_waitcnt lgkmcnt(1)
    s_nop 3
    s_mov_b32 s56, s55
    s_waitcnt lgkmcnt(0)
    s_cmp_eq_u32 s56, s55
    s_addc_u32 s57, s57, 0
    s_mov_b32 s55, s32
    s_load_dword s54, s[52:53], 21248 glc
    s_load_dword s55, s[52:53], 29440 glc
    s_waitcnt lgkmcnt(1)
    s_nop 3
    s_mov_b32 s56, s55
    s_waitcnt lgkmcnt(0)
    s_cmp_eq_u32 s56, s55
    s_addc_u32 s57, s57, 0
    s_mov_b32 s55, s32
    s_load_dword s54, s[52:53], 1024 glc
    s_load_dword s55, s[52:53], 9216 glc
    s_waitcnt lgkmcnt(1)
    s_nop 3
    s_mov_b32 s56, s55
    s_waitcnt lgkmcnt(0)
    s_cmp_eq_u32 s56, s55
    s_addc_u32 s57, s57, 0
    s_cmp_ge_u32 s57, 3
    s_cselect_b32 s56, 8192, 0
    v_mov_b32 v60, s56
    v_mov_b32 v61, 0
    v_mov_b32 v36, 512
    s_branch L_chpub
L_h1:
    s_mov_b32 s52, 1280
L_gate:
    v_mov_b32 v61, v60
    v_mul_u32_u24 v44, 20, v1
    v_add_u32 v46, s52, v44
    global_load_dwordx4 v[32:35], v46, s[4:5]
    global_load_dword v36, v46, s[4:5] offset:16
    global_load_dwordx4 v[40:43], v44, s[22:23]
    global_load_dword v44, v44, s[22:23] offset:16
    v_mov_b32 v62, 0
    s_waitcnt vmcnt(0)
    v_lshlrev_b32 v48, 16, v32
    v_and_b32 v49, 0xffff0000, v32
    v_lshlrev_b32 v50, 16, v40
    v_and_b32 v51, 0xffff0000, v40
    v_mul_f32 v48, v48, v50
    v_mul_f32 v49, v49, v51
    v_cvt_pk_bf16_f32 v48, v48, v49
    v_and_b32 v49, 0xffff0000, v48
    v_lshlrev_b32 v48, 16, v48
    v_add_f32 v62, v62, v49
    v_add_f32 v62, v62, v48
    v_lshlrev_b32 v48, 16, v33
    v_and_b32 v49, 0xffff0000, v33
    v_lshlrev_b32 v50, 16, v41
    v_and_b32 v51, 0xffff0000, v41
    v_mul_f32 v48, v48, v50
    v_mul_f32 v49, v49, v51
    v_cvt_pk_bf16_f32 v48, v48, v49
    v_and_b32 v49, 0xffff0000, v48
    v_lshlrev_b32 v48, 16, v48
    v_add_f32 v62, v62, v49
    v_add_f32 v62, v62, v48
    v_lshlrev_b32 v48, 16, v34
    v_and_b32 v49, 0xffff0000, v34
    v_lshlrev_b32 v50, 16, v42
    v_and_b32 v51, 0xffff0000, v42
    v_mul_f32 v48, v48, v50
    v_mul_f32 v49, v49, v51
    v_cvt_pk_bf16_f32 v48, v48, v49
    v_and_b32 v49, 0xffff0000, v48
    v_lshlrev_b32 v48, 16, v48
    v_add_f32 v62, v62, v49
    v_add_f32 v62, v62, v48
    v_lshlrev_b32 v48, 16, v35
    v_and_b32 v49, 0xffff0000, v35
    v_lshlrev_b32 v50, 16, v43
    v_and_b32 v51, 0xffff0000, v43
    v_mul_f32 v48, v48, v50
    v_mul_f32 v49, v49, v51
    v_cvt_pk_bf16_f32 v48, v48, v49
    v_and_b32 v49, 0xffff0000, v48
    v_lshlrev_b32 v48, 16, v48
    v_add_f32 v62, v62, v49
    v_add_f32 v62, v62, v48
    v_lshlrev_b32 v48, 16, v36
    v_and_b32 v49, 0xffff0000, v36
    v_lshlrev_b32 v50, 16, v44
    v_and_b32 v51, 0xffff0000, v44
    v_mul_f32 v48, v48, v50
    v_mul_f32 v49, v49, v51
    v_cvt_pk_bf16_f32 v48, v48, v49
    v_and_b32 v49, 0xffff0000, v48
    v_lshlrev_b32 v48, 16, v48
    v_add_f32 v62, v62, v49
    v_add_f32 v62, v62, v48
    s_nop 1
    v_add_f32_dpp v62, v62, v62 row_ror:8 row_mask:0xf bank_mask:0xf
    s_nop 1
    v_add_f32_dpp v62, v62, v62 row_ror:4 row_mask:0xf bank_mask:0xf
    s_nop 1
    v_add_f32_dpp v62, v62, v62 row_ror:2 row_mask:0xf bank_mask:0xf
    s_nop 1
    v_add_f32_dpp v62, v62, v62 row_ror:1 row_mask:0xf bank_mask:0xf
    s_nop 1
    v_add_f32_dpp v62, v62, v62 row_bcast:15 row_mask:0xa bank_mask:0xf
    s_nop 1
    v_add_f32_dpp v62, v62, v62 row_bcast:31 row_mask:0xc bank_mask:0xf
    s_nop 0
    v_readlane_b32 s51, v62, 63
    s_nop 1
    v_mov_b32 v62, s51
    v_cvt_pk_bf16_f32 v62, v62, v62
    v_lshlrev_b32 v62, 16, v62
    v_mul_f32 v62, 0xbfb8aa3b, v62
    v_exp_f32 v62, v62
    s_nop 0
    v_add_f32 v62, 1.0, v62
    v_rcp_f32 v62, v62
    s_nop 0
    v_cvt_pk_bf16_f32 v60, v62, v62
    v_lshlrev_b32 v60, 16, v60
    s_sub_u32 s52, s52, 1280
    s_cbranch_scc0 L_gate
    v_mov_b32 v36, 528
L_chpub:
    v_or_b32 v60, s68, v60
    v_or_b32 v61, s69, v61
    v_mov_b32 v62, s70
    v_mov_b32 v63, s71
    s_mov_b64 exec, 1
    buffer_store_dwordx4 v[60:63], v36, s[36:39], 0 offen sc1
    s_mov_b64 exec, -1
    s_branch L_hq
L_h0:
    s_getreg_b32 s52, hwreg(HW_REG_XCC_ID, 0, 8)
    v_mov_b32 v32, s32
    v_mov_b32 v33, s52
    s_and_b32 s52, s2, -8
    v_mov_b32 v34, s52
    s_lshl_b32 s53, s28, 8
    s_add_u32 s53, s53, 1024
    s_mov_b64 exec, 1
    buffer_store_dwordx2 v[32:33], v34, s[36:39], s53 offen
    s_mov_b64 exec, -1
    v_and_b32 v34, 31, v1
    v_lshlrev_b32 v34, 3, v34
    v_lshlrev_b32 v15, 4, v1
    v_add_u32 v14, 134656, v15
    s_mov_b32 s54, 2
L_hello:
    buffer_load_dwordx2 v[36:37], v34, s[36:39], s53 offen sc1
    s_waitcnt vmcnt(0)
    v_cmp_ne_u64 vcc, v[36:37], v[32:33]
    s_cbranch_vccz L_hellod
    s_sub_u32 s54, s54, 1
    s_cbranch_scc0 L_hello
L_hellod:
    s_lshl_b32 s52, s29, 10
    s_add_u32 s52, s52, 4096
    s_add_u32 s53, s52, 262144
    v_and_b32 v16, 7, v3
    v_lshlrev_b32 v16, 7, v16
    v_lshrrev_b32 v17, 3, v3
    v_lshl_add_u32 v16, v17, 6, v16
    v_lshl_add_u32 v16, v2, 4, v16
    s_cmp_eq_u64 vcc, 0
    s_cselect_b32 s65, 2, 1
    v_mov_b32 v33, s65
    ds_write_b32 v24, v33 offset:48
L_p1wait:
    ds_read_b32 v26, v24 offset:12
    s_waitcnt lgkmcnt(0)
    v_cmp_le_u32 vcc, 4, v26
    s_cbranch_vccnz L_p1wait_ok
    s_sleep 1
    s_sub_u32 s49, s49, 1
    s_cbranch_scc0 L_p1wait
    s_endpgm
L_p1wait_ok:
    ds_read_b128 v[32:35], v14 offset:0
    ds_read_b128 v[36:39], v14 offset:2048
    ds_read_b128 v[40:43], v14 offset:4096
    ds_read_b128 v[44:47], v14 offset:6144
    ds_read_b128 v[48:51], v14 offset:1024
    ds_read_b128 v[52:55], v14 offset:3072
    ds_read_b128 v[56:59], v14 offset:5120
    ds_read_b128 v[60:63], v14 offset:7168
    s_waitcnt lgkmcnt(4)
    v_pk_add_f32 v[32:33], v[32:33], v[36:37]
    v_pk_add_f32 v[40:41], v[40:41], v[44:45]
    v_pk_add_f32 v[34:35], v[34:35], v[38:39]
    v_pk_add_f32 v[42:43], v[42:43], v[46:47]
    v_pk_add_f32 v[32:33], v[32:33], v[40:41]
    v_pk_add_f32 v[34:35], v[34:35], v[42:43]
    v_and_or_b32 v32, v32, v12, s68
    v_and_or_b32 v33, v33, v12, s69
    v_and_or_b32 v34, v34, v12, s70
    v_and_or_b32 v35, v35, v12, s71
    s_cmp_eq_u32 s65, 2
    s_cbranch_scc0 L_pl2
    buffer_store_dwordx4 v[32:35], v15, s[36:39], s52 offen
L_pd2:
    s_waitcnt lgkmcnt(0)
    s_cmp_ge_u32 s67, 27
    s_cbranch_scc1 L_nogu2
    v_pk_add_f32 v[48:49], v[48:49], v[52:53]
    v_pk_add_f32 v[56:57], v[56:57], v[60:61]
    v_pk_add_f32 v[50:51], v[50:51], v[54:55]
    v_pk_add_f32 v[58:59], v[58:59], v[62:63]
    v_pk_add_f32 v[48:49], v[48:49], v[56:57]
    v_pk_add_f32 v[50:51], v[50:51], v[58:59]
    v_and_or_b32 v48, v48, v12, s68
    v_and_or_b32 v49, v49, v12, s69
    v_and_or_b32 v50, v50, v12, s70
    v_and_or_b32 v51, v51, v12, s71
    s_cmp_eq_u32 s65, 2
    s_cbranch_scc0 L_pl3
    buffer_store_dwordx4 v[48:51], v16, s[36:39], s53 offen
L_pd3:
L_nogu2:
    v_lshrrev_b32 v14, 5, v1
    v_and_b32 v15, 31, v1
    v_lshlrev_b32 v13, 10, v14
    v_lshl_add_u32 v13, v15, 4, v13
    s_lshr_b32 s53, s31, 2
    s_lshl_b32 s53, s53, 9
    s_lshl_b32 s52, s30, 13
    s_add_u32 s52, s52, s53
    s_add_u32 s52, s52, 4096
    s_add_u32 s53, s52, 4096
    v_and_b32 v15, 1, v2
    v_lshlrev_b32 v15, 3, v15
    v_lshl_add_u32 v15, v3, 4, v15
    v_lshl_add_u32 v15, v14, 2, v15
    v_add_u32 v15, 131072, v15
L_qgate:
    ds_read_b32 v26, v25 offset:32
    s_waitcnt lgkmcnt(0)
    v_cmp_le_u32 vcc, 3, v26
    s_cbranch_vccnz L_qgate_ok
    s_sleep 2
    s_sub_u32 s49, s49, 1
    s_cbranch_scc0 L_qgate
    s_endpgm
L_qgate_ok:
L_qpoll:
    buffer_load_dwordx4 v[32:35], v13, s[36:39], s52 offen sc1
    buffer_load_dwordx4 v[36:39], v13, s[36:39], s52 offen offset:2048 sc1
    buffer_load_dwordx4 v[40:43], v13, s[36:39], s53 offen sc1
    buffer_load_dwordx4 v[44:47], v13, s[36:39], s53 offen offset:2048 sc1
    s_waitcnt vmcnt(0)
    v_xor_b32 v32, s68, v32
    v_xor_b32 v33, s69, v33
    v_xor_b32 v34, s70, v34
    v_xor_b32 v35, s71, v35
    v_xor_b32 v36, s68, v36
    v_xor_b32 v37, s69, v37
    v_xor_b32 v38, s70, v38
    v_xor_b32 v39, s71, v39
    v_xor_b32 v40, s68, v40
    v_xor_b32 v41, s69, v41
    v_xor_b32 v42, s70, v42
    v_xor_b32 v43, s71, v43
    v_xor_b32 v44, s68, v44
    v_xor_b32 v45, s69, v45
    v_xor_b32 v46, s70, v46
    v_xor_b32 v47, s71, v47
    v_or_b32 v48, v32, v33
    v_or3_b32 v48, v48, v34, v35
    v_or3_b32 v48, v48, v36, v37
    v_or3_b32 v48, v48, v38, v39
    v_or3_b32 v48, v48, v40, v41
    v_or3_b32 v48, v48, v42, v43
    v_or3_b32 v48, v48, v44, v45
    v_or3_b32 v48, v48, v46, v47
    v_cmp_ne_u32_sdwa vcc, v48, 0 src0_sel:BYTE_0 src1_sel:DWORD
    s_cbranch_vccnz L_qpoll_re
    v_pk_add_f32 v[32:33], v[32:33], v[36:37]
    v_pk_add_f32 v[40:41], v[40:41], v[44:45]
    v_pk_add_f32 v[34:35], v[34:35], v[38:39]
    v_pk_add_f32 v[42:43], v[42:43], v[46:47]
    v_pk_add_f32 v[32:33], v[32:33], v[40:41]
    v_pk_add_f32 v[34:35], v[34:35], v[42:43]
    s_nop 1
    v_permlane32_swap_b32 v32, v34
    v_permlane32_swap_b32 v33, v35
    v_add_f32 v32, v32, v34
    v_add_f32 v33, v33, v35
    v_cvt_pk_bf16_f32 v32, v32, v33
    v_mov_b32 v33, 1
    ds_write_b32 v15, v32
    ds_write_b32 v24, v33 offset:0
    s_cmp_ge_u32 s67, 27
    s_cbranch_scc1 L_hq
    v_lshrrev_b32 v13, 3, v1
    v_lshlrev_b32 v13, 10, v13
    v_and_b32 v14, 7, v1
    v_lshl_add_u32 v13, v14, 4, v13
    s_lshl_b32 s52, s30, 13
    s_lshl_b32 s53, s31, 7
    s_add_u32 s52, s52, s53
    s_add_u32 s52, s52, 266240
    v_lshlrev_b32 v14, 4, v14
    v_lshl_add_u32 v14, v2, 2, v14
    v_lshlrev_b32 v15, 3, v2
    v_bfe_u32 v15, s33, v15, 8
    s_lshl3_add_u32 s53, s67, s31
    s_lshl_b32 s53, s53, 6
    s_add_u32 s53, s53, 532480
L_gpoll:
    buffer_load_dwordx4 v[32:35], v13, s[36:39], s52 offen sc1
    s_waitcnt vmcnt(0)
    v_xor_b32 v32, s68, v32
    v_xor_b32 v33, s69, v33
    v_xor_b32 v34, s70, v34
    v_xor_b32 v35, s71, v35
    v_or_b32 v48, v32, v33
    v_or3_b32 v48, v48, v34, v35
    v_cmp_ne_u32_sdwa vcc, v48, 0 src0_sel:BYTE_0 src1_sel:DWORD
    s_cbranch_vccnz L_gpoll_re
    v_permlane32_swap_b32 v32, v34
    v_permlane32_swap_b32 v33, v35
    v_pk_add_f32 v[32:33], v[32:33], v[34:35]
    s_nop 1
    v_permlane16_swap_b32 v32, v33
    v_add_f32 v32, v32, v33
    s_nop 1
    v_add_f32_dpp v32, v32, v32 row_ror:8 row_mask:0xf bank_mask:0xf
    v_cvt_pk_bf16_f32 v32, v32, v32
    v_lshlrev_b32 v32, 16, v32
    v_mul_f32 v48, v32, v32
    v_mul_f32 v48, 0x3d372713, v48
    v_mov_b32_dpp v33, v32 row_shl:4 row_mask:0xf bank_mask:0xf
    v_fma_f32 v48, v48, v32, v32
    v_mul_f32 v48, 0xc0135761, v48
    v_exp_f32 v48, v48
    s_nop 0
    v_add_f32 v48, 1.0, v48
    v_rcp_f32 v48, v48
    s_nop 0
    v_mul_f32 v32, v32, v48
    v_cvt_pk_bf16_f32 v32, v32, v32
    v_lshlrev_b32 v32, 16, v32
    v_mul_f32 v32, v32, v33
    v_cvt_pk_bf16_f32 v32, v32, v32
    v_lshlrev_b32 v32, 16, v32
    v_or_b32 v32, v32, v15
    s_mov_b32 exec_lo, 0x000f000f
    s_mov_b32 exec_hi, 0x000f000f
    s_cmp_eq_u32 s65, 2
    s_cbranch_scc0 L_pl4
    buffer_store_dword v32, v14, s[36:39], s53 offen
L_pd4:
    s_mov_b64 exec, -1
L_hq:
    s_lshl_b32 s51, s34, 15
    v_and_b32 v21, 3, v3
    v_lshrrev_b32 v22, 2, v3
    v_lshl_add_u32 v21, v21, 2, v22
    v_lshlrev_b32 v21, 8, v21
    v_xor_b32 v22, v2, v3
    v_lshlrev_b32 v22, 4, v22
    v_add3_u32 v17, v21, v22, s51
    v_xor_b32 v18, 64, v17
    v_xor_b32 v19, 0x80, v17
    v_xor_b32 v20, 0xc0, v17
    v_lshlrev_b32 v23, 4, v2
    v_add_u32 v23, 131072, v23
L_qwait:
    ds_read_b32 v26, v24 offset:0
    s_waitcnt lgkmcnt(0)
    v_cmp_ne_u32 vcc, 0, v26
    s_cbranch_vccnz L_qwait_ok
    s_sleep 2
    s_sub_u32 s49, s49, 1
    s_cbranch_scc0 L_qwait
    s_endpgm
L_qwait_ok:
    ds_read_b128 v[32:35], v23 offset:0
    ds_read_b128 v[36:39], v23 offset:64
    ds_read_b128 v[40:43], v23 offset:128
    ds_read_b128 v[44:47], v23 offset:192
    ds_read_b32 v27, v24 offset:48
    s_mov_b32 s52, 0x00010001
    s_mov_b32 s53, 0x00010001
    s_mov_b32 s56, 0
L_qk:
    ds_read_b32 v26, v25 offset:32
    s_waitcnt lgkmcnt(0)
    v_cmp_lt_u32 vcc, s56, v26
    s_cbranch_vccnz L_qk_ok
    s_sleep 2
    s_sub_u32 s49, s49, 1
    s_cbranch_scc0 L_qk
    s_endpgm
L_qk_ok:
    ds_read_b128 v[48:51], v17
    ds_read_b128 v[52:55], v18
    ds_read_b128 v[56:59], v19
    ds_read_b128 v[60:63], v20
    v_add_u32 v17, 4096, v17
    v_add_u32 v18, 4096, v18
    v_add_u32 v19, 4096, v19
    v_add_u32 v20, 4096, v20
    s_lshl_b64 s[54:55], s[52:53], 1
    s_add_u32 s56, s56, 1
    s_waitcnt lgkmcnt(3)
    v_mfma_f32_16x16x32_bf16 v[64:67], v[48:51], v[32:35], 0
    s_waitcnt lgkmcnt(2)
    v_mfma_f32_16x16x32_bf16 v[64:67], v[52:55], v[36:39], v[64:67]
    s_waitcnt lgkmcnt(1)
    v_mfma_f32_16x16x32_bf16 v[64:67], v[56:59], v[40:43], v[64:67]
    s_waitcnt lgkmcnt(0)
    v_mfma_f32_16x16x32_bf16 v[64:67], v[60:63], v[44:47], v[64:67]
    s_nop 7
    v_cndmask_b32 v68, v68, v64, s[52:53]
    v_cndmask_b32 v69, v69, v65, s[52:53]
    v_cndmask_b32 v68, v68, v66, s[54:55]
    v_cndmask_b32 v69, v69, v67, s[54:55]
    s_lshl_b64 s[52:53], s[52:53], 2
    s_cmp_lt_u32 s56, 8
    s_cbranch_scc1 L_qk
    v_readfirstlane_b32 s65, v27
    v_cvt_pk_bf16_f32 v68, v68, v69
    v_and_b32 v69, 0xffff0000, v68
    v_lshlrev_b32 v68, 16, v68
    v_mul_f32 v68, 0x3db504f3, v68
    v_mul_f32 v69, 0x3db504f3, v69
    v_cvt_pk_bf16_f32 v68, v68, v69
    v_and_b32 v69, 0xffff0000, v68
    v_lshlrev_b32 v68, 16, v68
    v_max_f32 v70, v68, v69
    s_nop 1
    v_max_f32_dpp v70, v70, v70 row_ror:8 row_mask:0xf bank_mask:0xf
    s_nop 1
    v_max_f32_dpp v70, v70, v70 row_ror:4 row_mask:0xf bank_mask:0xf
    s_nop 1
    v_max_f32_dpp v70, v70, v70 row_ror:2 row_mask:0xf bank_mask:0xf
    s_nop 1
    v_max_f32_dpp v70, v70, v70 row_ror:1 row_mask:0xf bank_mask:0xf
    s_nop 1
    v_max_f32_dpp v70, v70, v70 row_bcast:15 row_mask:0xa bank_mask:0xf
    s_nop 1
    v_max_f32_dpp v70, v70, v70 row_bcast:31 row_mask:0xc bank_mask:0xf
    s_nop 0
    v_readlane_b32 s52, v70, 63
    s_nop 1
    v_subrev_f32 v68, s52, v68
    v_subrev_f32 v69, s52, v69
    v_mul_f32 v68, 0x3fb8aa3b, v68
    v_mul_f32 v69, 0x3fb8aa3b, v69
    v_exp_f32 v68, v68
    v_exp_f32 v69, v69
    s_lshl_b32 s54, s34, 8
    s_add_u32 s54, s54, 131584
    v_lshl_add_u32 v22, v1, 2, s54
    v_cvt_pk_bf16_f32 v71, v68, v69
    v_add_f32 v70, v68, v69
    ds_write_b32 v22, v71
    s_nop 1
    v_add_f32_dpp v70, v70, v70 row_ror:8 row_mask:0xf bank_mask:0xf
    s_nop 1
    v_add_f32_dpp v70, v70, v70 row_ror:4 row_mask:0xf bank_mask:0xf
    s_nop 1
    v_add_f32_dpp v70, v70, v70 row_ror:2 row_mask:0xf bank_mask:0xf
    s_nop 1
    v_add_f32_dpp v70, v70, v70 row_ror:1 row_mask:0xf bank_mask:0xf
    s_nop 1
    v_add_f32_dpp v70, v70, v70 row_bcast:15 row_mask:0xa bank_mask:0xf
    s_nop 1
    v_add_f32_dpp v70, v70, v70 row_bcast:31 row_mask:0xc bank_mask:0xf
    s_nop 0
    v_readlane_b32 s53, v70, 63
    s_nop 1
    v_mov_b32 v68, s52
    v_mov_b32 v69, s53
    v_lshl_add_u32 v22, s34, 3, v24
    v_mov_b32 v21, 1
    ds_write_b64 v22, v[68:69] offset:64
    s_mov_b64 exec, 1
    ds_add_rtn_u32 v26, v24, v21 offset:16
    ds_read_b128 v[32:35], v24 offset:64
    ds_read_b128 v[36:39], v24 offset:80
    s_waitcnt lgkmcnt(0)
    v_cmp_eq_u32 vcc, 3, v26
    s_cbranch_vccz L_nomlpub
    v_max_f32 v40, v32, v34
    v_max3_f32 v40, v40, v36, v38
    v_sub_f32 v32, v32, v40
    v_mul_f32 v32, 0x3fb8aa3b, v32
    v_exp_f32 v32, v32
    v_sub_f32 v34, v34, v40
    v_mul_f32 v34, 0x3fb8aa3b, v34
    v_exp_f32 v34, v34
    v_sub_f32 v36, v36, v40
    v_mul_f32 v36, 0x3fb8aa3b, v36
    v_exp_f32 v36, v36
    v_sub_f32 v38, v38, v40
    v_mul_f32 v38, 0x3fb8aa3b, v38
    v_exp_f32 v38, v38
    v_mul_f32 v41, v32, v33
    v_fmac_f32 v41, v34, v35
    v_fmac_f32 v41, v36, v37
    v_fmac_f32 v41, v38, v39
    v_mov_b64 v[42:43], 0
    v_mov_b32 v44, 0
    s_lshl_b32 s54, s29, 4
    s_add_u32 s54, s54, 528384
    v_and_or_b32 v40, v40, v12, s68
    v_and_or_b32 v41, v41, v12, s69
    v_and_or_b32 v42, v42, v12, s70
    v_and_or_b32 v43, v43, v12, s71
    s_cmp_eq_u32 s65, 2
    s_cbranch_scc0 L_pl5
    buffer_store_dwordx4 v[40:43], v44, s[36:39], s54 offen
L_pd5:
    s_mov_b64 exec, -1
    v_and_b32 v15, 7, v1
    v_lshlrev_b32 v15, 4, v15
    v_and_b32 v17, 1, v1
    v_lshlrev_b32 v16, 4, v17
    v_lshl_add_u32 v17, v17, 3, v24
    s_and_b32 s54, s54, -128
L_mlgate:
    ds_read_b32 v26, v25 offset:32
    s_waitcnt lgkmcnt(0)
    v_cmp_le_u32 vcc, 10, v26
    s_cbranch_vccnz L_mlgate_ok
    s_sleep 4
    s_sub_u32 s49, s49, 1
    s_cbranch_scc0 L_mlgate
    s_endpgm
L_mlgate_ok:
L_mlpoll:
    buffer_load_dwordx4 v[72:75], v15, s[36:39], s54 offen sc1
    buffer_load_dwordx4 v[76:79], v16, s[36:39], 0 offen offset:512 sc1
    s_waitcnt vmcnt(0)
    v_xor_b32 v72, s68, v72
    v_xor_b32 v73, s69, v73
    v_xor_b32 v74, s70, v74
    v_xor_b32 v75, s71, v75
    v_xor_b32 v76, s68, v76
    v_xor_b32 v77, s69, v77
    v_xor_b32 v78, s70, v78
    v_xor_b32 v79, s71, v79
    v_or_b32 v80, v72, v73
    v_or3_b32 v80, v80, v74, v75
    v_or3_b32 v80, v80, v76, v77
    v_or3_b32 v80, v80, v78, v79
    v_cmp_ne_u32_sdwa vcc, v80, 0 src0_sel:BYTE_0 src1_sel:DWORD
    s_cbranch_vccnz L_mlpoll_re
    ds_write_b64 v17, v[76:77] offset:96
    v_max_f32_dpp v74, v72, v72 quad_perm:[1,0,3,2] row_mask:0xf bank_mask:0xf
    s_nop 1
    v_max_f32_dpp v74, v74, v74 quad_perm:[2,3,0,1] row_mask:0xf bank_mask:0xf
    v_sub_f32 v72, v72, v74
    v_mul_f32 v72, 0x3fb8aa3b, v72
    v_exp_f32 v72, v72
    s_nop 0
    v_mul_f32 v73, v72, v73
    s_nop 1
    v_add_f32_dpp v73, v73, v73 quad_perm:[1,0,3,2] row_mask:0xf bank_mask:0xf
    s_nop 1
    v_add_f32_dpp v73, v73, v73 quad_perm:[2,3,0,1] row_mask:0xf bank_mask:0xf
    v_rcp_f32 v73, v73
    s_lshl_b64 s[54:55], 1, s31
    v_mul_f32 v72, v72, v73
    v_mov_b32 v73, 1
    s_mov_b64 exec, s[54:55]
    ds_write_b64 v24, v[72:73] offset:56
L_nomlpub:
    s_mov_b64 exec, -1
    v_mul_u32_u24 v13, 10240, v2
    v_lshl_add_u32 v13, v3, 4, v13
    v_lshrrev_b32 v14, 3, v3
    v_bfe_u32 v16, v3, 2, 1
    s_cmp_eq_u32 s28, 0
    s_cselect_b32 s65, s65, 1
    s_cmp_ge_u32 s31, 5
    s_cbranch_scc1 L_wdsetup
    s_mov_b32 s40, s12
    s_mov_b32 s41, s13
    s_mov_b32 s56, 0
    s_lshl2_add_u32 s57, s30, s34
    s_mov_b32 s58, s31
    s_mov_b32 s59, s30
    v_and_b32 v17, 3, v3
    v_lshl_add_u32 v15, v14, 2, v17
    v_lshl_add_u32 v16, v2, 1, v16
    v_lshlrev_b32 v16, 7, v16
    v_lshl_add_u32 v16, v15, 4, v16
    s_xor_b32 s44, s68, 0x80
    s_xor_b32 s45, s69, 0x80
    s_xor_b32 s46, s70, 0x80
    s_xor_b32 s47, s71, 0x80
    s_lshl3_add_u32 s60, s30, s34
    s_lshl_b32 s60, s60, 10
    s_add_u32 s60, s60, 4096
    s_branch L_mid
L_pl2:
    buffer_store_dwordx4 v[32:35], v15, s[36:39], s52 offen sc1
    s_branch L_pd2
L_pl3:
    buffer_store_dwordx4 v[48:51], v16, s[36:39], s53 offen sc1
    s_branch L_pd3
L_qpoll_re:
    s_sleep 1
    s_sub_u32 s49, s49, 1
    s_cbranch_scc0 L_qpoll
    s_endpgm
L_gpoll_re:
    s_sleep 1
    s_sub_u32 s49, s49, 1
    s_cbranch_scc0 L_gpoll
    s_endpgm
L_pl4:
    buffer_store_dword v32, v14, s[36:39], s53 offen sc1
    s_branch L_pd4
L_pl5:
    buffer_store_dwordx4 v[40:43], v44, s[36:39], s54 offen sc1
    s_branch L_pd5
L_mlpoll_re:
    s_sleep 2
    s_sub_u32 s49, s49, 1
    s_cbranch_scc0 L_mlpoll
    s_endpgm
L_wdsetup:
    s_mul_i32 s51, s64, 3
    s_add_u32 s51, s51, s31
    s_cmp_ge_u32 s51, 15
    s_cbranch_scc1 L_end
    s_cmp_eq_u32 s28, 0
    s_cbranch_scc1 L_end
    s_mov_b32 s40, s20
    s_mov_b32 s41, s21
    s_mov_b32 s42, 2211840
    s_cmp_ge_u32 s51, 10
    s_cselect_b32 s55, 1, 0
    s_cselect_b32 s58, 10, 5
    s_sub_u32 s58, s51, s58
    s_lshl1_add_u32 s57, s66, s55
    s_add_u32 s59, s57, 32
    s_lshl2_add_u32 s57, s57, s34
    s_mov_b32 s56, 2
    s_cmp_ge_u32 s57, 54
    s_cbranch_scc1 L_mid
    s_mov_b32 s56, 1
    s_lshl_b32 s60, s57, 8
    s_add_u32 s60, s60, 532480
    v_lshlrev_b32 v16, 4, v16
    v_lshl_add_u32 v16, v14, 5, v16
    v_lshl_add_u32 v16, v2, 6, v16
L_hpoll:
    buffer_load_dwordx4 v[72:75], v16, s[36:39], s60 offen sc1
    s_waitcnt vmcnt(0)
    v_xor_b32 v72, s68, v72
    v_xor_b32 v73, s69, v73
    v_xor_b32 v74, s70, v74
    v_xor_b32 v75, s71, v75
    v_or_b32 v80, v72, v73
    v_or3_b32 v80, v80, v74, v75
    v_cmp_ne_u32_sdwa vcc, v80, 0 src0_sel:BYTE_0 src1_sel:DWORD
    s_cbranch_vccnz L_hpoll_re
L_mid:
    s_lshl_b32 s54, s34, 10
    s_add_u32 s54, s54, 134656
    v_lshl_add_u32 v18, v1, 4, s54
    v_lshlrev_b32 v19, 4, v1
    v_add_u32 v19, 134656, v19
    v_mov_b64 v[64:65], 0
    v_mov_b64 v[66:67], 0
    v_lshrrev_b32 v14, 5, v1
    v_lshlrev_b32 v14, 9, v14
    v_lshl_add_u32 v14, v3, 5, v14
    v_and_b32 v17, 1, v2
    v_lshl_add_u32 v14, v17, 4, v14
    s_lshl_b32 s61, s58, 6
    s_add_u32 s61, s61, s59
    s_and_b32 s54, s61, -8
    s_add_u32 s61, s61, s54
    s_lshl_b32 s61, s61, 10
    s_add_u32 s61, s61, 1048576
    s_mul_i32 s54, s57, 40960
    s_lshl_b32 s55, s58, 8
    s_add_u32 s54, s54, s55
    s_add_u32 s55, s54, 5120
L_eg:
    ds_read_b32 v26, v25 offset:32
    s_waitcnt lgkmcnt(0)
    v_cmp_lt_u32 vcc, 10, v26
    s_cbranch_vccnz L_eg_ok
    s_sleep 1
    s_sub_u32 s49, s49, 1
    s_cbranch_scc0 L_eg
    s_endpgm
L_eg_ok:
    ds_read_b32 v22, v24 offset:96
    s_cmp_eq_u32 s56, 2
    s_cbranch_scc1 L_p2z
    buffer_load_dwordx4 v[32:35], v13, s[40:43], s54 offen offset:0 nt
    buffer_load_dwordx4 v[36:39], v13, s[40:43], s54 offen offset:1280 nt
    buffer_load_dwordx4 v[40:43], v13, s[40:43], s54 offen offset:2560 nt
    buffer_load_dwordx4 v[44:47], v13, s[40:43], s54 offen offset:3840 nt
L_p2go:
    ds_read_b32 v26, v24 offset:20
    s_waitcnt lgkmcnt(0)
    v_cmp_le_u32 vcc, 4, v26
    s_cbranch_vccnz L_p2go_ok
    s_sleep 1
    s_sub_u32 s49, s49, 1
    s_cbranch_scc0 L_p2go
    s_endpgm
L_p2go_ok:
    buffer_load_dwordx4 v[48:51], v13, s[40:43], s55 offen offset:0 nt
    buffer_load_dwordx4 v[52:55], v13, s[40:43], s55 offen offset:1280 nt
    buffer_load_dwordx4 v[56:59], v13, s[40:43], s55 offen offset:2560 nt
    buffer_load_dwordx4 v[60:63], v13, s[40:43], s55 offen offset:3840 nt
    v_add_u32 v14, v14, v22
    s_cmp_eq_u32 s56, 1
    s_cbranch_scc1 L_p2wd
    s_waitcnt vmcnt(1)
    buffer_load_dwordx4 v[96:99], v16, s[36:39], s60 offen sc1
    s_sleep 1
    buffer_load_dwordx4 v[100:103], v16, s[36:39], s60 offen sc1
    .p2align 3
L_opoll:
    s_waitcnt vmcnt(1)
    v_xor_b32 v72, s44, v96
    v_xor_b32 v73, s45, v97
    v_xor_b32 v74, s46, v98
    v_xor_b32 v75, s47, v99
    v_or_b32 v80, v72, v73
    v_or3_b32 v80, v80, v74, v75
    v_cmp_ne_u32_sdwa vcc, v80, 0 src0_sel:BYTE_0 src1_sel:DWORD
    v_add_f32_dpp v72, v72, v72 quad_perm:[1,0,3,2] row_mask:0xf bank_mask:0xf
    v_add_f32_dpp v73, v73, v73 quad_perm:[1,0,3,2] row_mask:0xf bank_mask:0xf
    v_add_f32_dpp v74, v74, v74 quad_perm:[1,0,3,2] row_mask:0xf bank_mask:0xf
    v_add_f32_dpp v75, v75, v75 quad_perm:[1,0,3,2] row_mask:0xf bank_mask:0xf
    s_cbranch_vccz L_opoll_ok
    buffer_load_dwordx4 v[96:99], v16, s[36:39], s60 offen sc1
    s_waitcnt vmcnt(1)
    v_xor_b32 v72, s44, v100
    v_xor_b32 v73, s45, v101
    v_xor_b32 v74, s46, v102
    v_xor_b32 v75, s47, v103
    v_or_b32 v80, v72, v73
    v_or3_b32 v80, v80, v74, v75
    v_cmp_ne_u32_sdwa vcc, v80, 0 src0_sel:BYTE_0 src1_sel:DWORD
    s_cbranch_vccnz L_opoll_re
    v_add_f32_dpp v72, v72, v72 quad_perm:[1,0,3,2] row_mask:0xf bank_mask:0xf
    v_add_f32_dpp v73, v73, v73 quad_perm:[1,0,3,2] row_mask:0xf bank_mask:0xf
    v_add_f32_dpp v74, v74, v74 quad_perm:[1,0,3,2] row_mask:0xf bank_mask:0xf
    v_add_f32_dpp v75, v75, v75 quad_perm:[1,0,3,2] row_mask:0xf bank_mask:0xf
L_opoll_ok:
    v_add_f32_dpp v72, v72, v72 quad_perm:[2,3,0,1] row_mask:0xf bank_mask:0xf
    v_add_f32_dpp v73, v73, v73 quad_perm:[2,3,0,1] row_mask:0xf bank_mask:0xf
    v_add_f32_dpp v74, v74, v74 quad_perm:[2,3,0,1] row_mask:0xf bank_mask:0xf
    v_add_f32_dpp v75, v75, v75 quad_perm:[2,3,0,1] row_mask:0xf bank_mask:0xf
L_p2mm:
    v_cvt_pk_bf16_f32 v28, v72, v73
    v_cvt_pk_bf16_f32 v29, v74, v75
    v_perm_b32 v84, v28, v28, v4
    v_mov_b32_dpp v30, v28 row_half_mirror row_mask:0xf bank_mask:0xf
    v_mov_b32_dpp v31, v29 row_half_mirror row_mask:0xf bank_mask:0xf
    v_perm_b32 v85, v28, v28, v6
    v_perm_b32 v86, v30, v30, v8
    v_perm_b32 v87, v30, v30, v10
    v_perm_b32 v88, v28, v28, v5
    v_perm_b32 v89, v28, v28, v7
    v_perm_b32 v90, v30, v30, v9
    v_perm_b32 v91, v30, v30, v11
    v_mfma_f32_16x16x32_bf16 v[64:67], v[84:87], v[32:35], v[64:67]
    v_perm_b32 v92, v29, v29, v4
    v_perm_b32 v93, v29, v29, v6
    v_perm_b32 v94, v31, v31, v8
    v_perm_b32 v95, v31, v31, v10
    v_mfma_f32_16x16x32_bf16 v[64:67], v[88:91], v[36:39], v[64:67]
    v_perm_b32 v84, v29, v29, v5
    v_perm_b32 v85, v29, v29, v7
    v_perm_b32 v86, v31, v31, v9
    v_perm_b32 v87, v31, v31, v11
    v_mfma_f32_16x16x32_bf16 v[64:67], v[92:95], v[40:43], v[64:67]
    v_perm_b32 v88, v30, v30, v4
    v_perm_b32 v89, v30, v30, v6
    v_perm_b32 v90, v28, v28, v8
    v_perm_b32 v91, v28, v28, v10
    v_mfma_f32_16x16x32_bf16 v[64:67], v[84:87], v[44:47], v[64:67]
    v_perm_b32 v92, v30, v30, v5
    v_perm_b32 v93, v30, v30, v7
    v_perm_b32 v94, v28, v28, v9
    v_perm_b32 v95, v28, v28, v11
    v_mfma_f32_16x16x32_bf16 v[64:67], v[88:91], v[48:51], v[64:67]
    v_perm_b32 v84, v31, v31, v4
    v_perm_b32 v85, v31, v31, v6
    v_perm_b32 v86, v29, v29, v8
    v_perm_b32 v87, v29, v29, v10
    v_mfma_f32_16x16x32_bf16 v[64:67], v[92:95], v[52:55], v[64:67]
    v_perm_b32 v88, v31, v31, v5
    v_perm_b32 v89, v31, v31, v7
    v_perm_b32 v90, v29, v29, v9
    v_perm_b32 v91, v29, v29, v11
    v_mfma_f32_16x16x32_bf16 v[64:67], v[84:87], v[56:59], v[64:67]
    s_nop 0
    v_mfma_f32_16x16x32_bf16 v[64:67], v[88:91], v[60:63], v[64:67]
    s_nop 7
L_p2red:
    ds_write_b128 v18, v[64:67]
    s_mov_b64 exec, 1
    ds_add_rtn_u32 v21, v24, v21 offset:8
    s_mov_b64 exec, -1
    ds_read_b128 v[32:35], v19 offset:0
    ds_read_b128 v[36:39], v19 offset:1024
    ds_read_b128 v[40:43], v19 offset:2048
    ds_read_b128 v[44:47], v19 offset:3072
    s_cmp_eq_u32 s65, 2
    s_waitcnt lgkmcnt(2)
    v_pk_add_f32 v[32:33], v[32:33], v[36:37]
    v_pk_add_f32 v[34:35], v[34:35], v[38:39]
    v_cmp_eq_u32 vcc, 3, v21
    s_waitcnt lgkmcnt(0)
    v_pk_add_f32 v[40:41], v[40:41], v[44:45]
    v_pk_add_f32 v[42:43], v[42:43], v[46:47]
    v_pk_add_f32 v[32:33], v[32:33], v[40:41]
    v_pk_add_f32 v[34:35], v[34:35], v[42:43]
    v_and_or_b32 v32, v32, v12, s68
    v_and_or_b32 v33, v33, v12, s69
    v_and_or_b32 v34, v34, v12, s70
    v_and_or_b32 v35, v35, v12, s71
    s_cbranch_vccz L_Hend
    s_cbranch_scc1 L_pl6
    buffer_store_dwordx4 v[32:35], v14, s[36:39], s61 offen sc1
L_pd6:
L_Hend:
    s_cmp_lg_u32 s28, 0
    s_cbranch_scc1 L_end
    s_mul_i32 s58, s64, 5
    s_add_u32 s58, s58, s31
    s_lshl2_add_u32 s58, s58, s34
    s_bfe_u32 s52, s58, 0x10003
    v_lshl_add_u32 v62, s52, 2, v24
    ds_read_b32 v62, v62 offset:104
    s_mov_b32 s40, s24
    s_mov_b32 s41, s25
    s_mov_b32 s42, 2560
    v_lshrrev_b32 v13, 2, v1
    v_and_b32 v14, 8, v13
    v_add_u32 v13, v13, v14
    v_and_b32 v14, 3, v1
    v_lshl_add_u32 v13, v13, 10, v22
    v_lshl_add_u32 v13, v14, 4, v13
    s_lshr_b32 s59, s58, 4
    s_lshl_b32 s53, s59, 17
    s_and_b32 s54, s58, 15
    s_lshl_b32 s54, s54, 6
    s_add_u32 s53, s53, s54
    s_add_u32 s53, s53, 1048576
    s_add_u32 s54, s53, 32768
    s_add_u32 s55, s53, 65536
    v_lshl_add_u32 v14, v14, 2, v2
    v_lshlrev_b32 v14, 1, v14
    s_mul_i32 s51, s52, 1280
    s_lshl_b32 s59, s59, 8
    s_add_u32 s51, s51, s59
    s_and_b32 s52, s58, 7
    s_lshl_b32 s52, s52, 5
    s_add_u32 s51, s51, s52
    v_mov_b32 v36, s68
    v_mov_b32 v37, s69
    v_mov_b32 v38, s70
    v_mov_b32 v39, s71
    s_waitcnt lgkmcnt(0)
    v_sub_f32 v63, 1.0, v62
    v_cvt_pk_bf16_f32 v63, v63, v63
    v_lshlrev_b32 v63, 16, v63
L_dpoll:
    s_mov_b32 exec_hi, 0xffffff
    buffer_load_dwordx4 v[36:39], v13, s[36:39], s55 offen sc1
    s_mov_b32 exec_hi, -1
    buffer_load_dwordx4 v[44:47], v13, s[36:39], s53 offen sc1
    buffer_load_dwordx4 v[48:51], v13, s[36:39], s54 offen sc1
    s_waitcnt vmcnt(2)
    v_xor_b32 v40, s68, v36
    v_xor_b32 v41, s69, v37
    v_xor_b32 v42, s70, v38
    v_xor_b32 v43, s71, v39
    v_or_b32 v52, v40, v41
    v_or3_b32 v52, v52, v42, v43
    v_cmp_ne_u32_sdwa vcc, v52, 0 src0_sel:BYTE_0 src1_sel:DWORD
    s_cbranch_vccnz L_dpoll_re
    buffer_load_dwordx4 v[64:67], v13, s[36:39], s53 offen sc1
    buffer_load_dwordx4 v[68:71], v13, s[36:39], s54 offen sc1
    v_permlane32_swap_b32 v40, v42
    v_permlane32_swap_b32 v41, v43
    v_pk_add_f32 v[40:41], v[40:41], v[42:43]
    s_nop 1
    v_permlane16_swap_b32 v40, v41
    v_add_f32 v40, v40, v41
    s_nop 1
    v_add_f32_dpp v40, v40, v40 row_ror:8 row_mask:0xf bank_mask:0xf
    s_nop 1
    v_add_f32_dpp v40, v40, v40 row_ror:4 row_mask:0xf bank_mask:0xf
    v_cvt_pk_bf16_f32 v40, v40, v40
    v_lshlrev_b32 v40, 16, v40
    v_mul_f32 v63, v63, v40
    v_cvt_pk_bf16_f32 v63, v63, v63
    v_lshlrev_b32 v63, 16, v63
    .p2align 3
L_apoll:
    s_waitcnt vmcnt(2)
    v_xor_b32 v24, s68, v44
    v_xor_b32 v25, s69, v45
    v_xor_b32 v26, s70, v46
    v_xor_b32 v27, s71, v47
    v_xor_b32 v28, s68, v48
    v_xor_b32 v29, s69, v49
    v_xor_b32 v30, s70, v50
    v_xor_b32 v31, s71, v51
    v_or_b32 v52, v24, v25
    v_or3_b32 v52, v52, v26, v27
    v_or3_b32 v52, v52, v28, v29
    v_or3_b32 v52, v52, v30, v31
    v_cmp_ne_u32_sdwa vcc, v52, 0 src0_sel:BYTE_0 src1_sel:DWORD
    v_pk_add_f32 v[24:25], v[24:25], v[28:29]
    v_pk_add_f32 v[26:27], v[26:27], v[30:31]
    s_cbranch_vccz L_apoll_ok
    s_mov_b64 exec, vcc
    buffer_load_dwordx4 v[44:47], v13, s[36:39], s53 offen sc1
    buffer_load_dwordx4 v[48:51], v13, s[36:39], s54 offen sc1
    s_waitcnt vmcnt(2)
    v_xor_b32 v24, s68, v64
    v_xor_b32 v25, s69, v65
    v_xor_b32 v26, s70, v66
    v_xor_b32 v27, s71, v67
    v_xor_b32 v28, s68, v68
    v_xor_b32 v29, s69, v69
    v_xor_b32 v30, s70, v70
    v_xor_b32 v31, s71, v71
    v_or_b32 v52, v24, v25
    v_or3_b32 v52, v52, v26, v27
    v_or3_b32 v52, v52, v28, v29
    v_or3_b32 v52, v52, v30, v31
    v_cmp_ne_u32_sdwa vcc, v52, 0 src0_sel:BYTE_0 src1_sel:DWORD
    v_pk_add_f32 v[24:25], v[24:25], v[28:29]
    v_pk_add_f32 v[26:27], v[26:27], v[30:31]
    s_cbranch_vccnz L_apoll_re
L_apoll_ok:
    s_mov_b64 exec, -1
    v_permlane32_swap_b32 v24, v26
    v_permlane32_swap_b32 v25, v27
    v_pk_add_f32 v[24:25], v[24:25], v[26:27]
    s_nop 1
    v_permlane16_swap_b32 v24, v25
    v_add_f32 v24, v24, v25
    s_nop 1
    v_add_f32_dpp v24, v24, v24 row_ror:8 row_mask:0xf bank_mask:0xf
    s_nop 1
    v_add_f32_dpp v24, v24, v24 row_ror:4 row_mask:0xf bank_mask:0xf
    v_fma_f32 v24, v62, v24, v63
    v_cvt_pk_bf16_f32 v24, v24, v24
    buffer_store_short v24, v14, s[40:43], s51 offen
    s_cmp_lg_u32 s51, 0
    s_cbranch_scc1 L_end
    v_mov_b32 v33, s32
    v_mov_b32 v34, 0
    s_mov_b64 exec, 1
    buffer_store_dword v33, v34, s[36:39], 0 offen
    s_endpgm
L_hpoll_re:
    s_sleep 4
    s_sub_u32 s49, s49, 1
    s_cbranch_scc0 L_hpoll
    s_endpgm
L_p2wd:
    s_waitcnt vmcnt(0)
    s_branch L_p2mm
L_p2z:
    s_waitcnt lgkmcnt(0)
    v_add_u32 v14, v14, v22
    s_branch L_p2red
L_opoll_re:
    buffer_load_dwordx4 v[100:103], v16, s[36:39], s60 offen sc1
    s_sub_u32 s49, s49, 1
    s_cbranch_scc0 L_opoll
    s_endpgm
L_pl6:
    buffer_store_dwordx4 v[32:35], v14, s[36:39], s61 offen
    s_branch L_pd6
L_dpoll_re:
    s_sub_u32 s49, s49, 1
    s_cbranch_scc0 L_dpoll
    s_endpgm
L_apoll_re:
    s_mov_b64 exec, vcc
    buffer_load_dwordx4 v[64:67], v13, s[36:39], s53 offen sc1
    buffer_load_dwordx4 v[68:71], v13, s[36:39], s54 offen sc1
    s_sub_u32 s49, s49, 1
    s_cbranch_scc0 L_apoll
    s_endpgm
.section .rodata,"a"
.p2align 6
.amdhsa_kernel gated_mix__sliding_block_cached__geglu_ffn__decode_kernel
  .amdhsa_next_free_vgpr 192
  .amdhsa_next_free_sgpr 72
  .amdhsa_accum_offset 192
  .amdhsa_group_segment_fixed_size 0
  .amdhsa_kernarg_size 104
  .amdhsa_user_sgpr_count 2
  .amdhsa_user_sgpr_kernarg_segment_ptr 1
  .amdhsa_system_sgpr_workgroup_id_x 1
  .amdhsa_float_denorm_mode_32 3
.end_amdhsa_kernel
```
